```python
import torch

def _softmax(x, axis=-1):
    return torch.softmax(x, dim=axis)
def _gelu(x):
    return torch.nn.functional.gelu(x, approximate="tanh")
def _silu(x):
    return torch.nn.functional.silu(x)
def _sigmoid(x):
    return torch.sigmoid(x)
def _layernorm(x, axis=-1, eps=1e-5):
    m = x.mean(dim=axis, keepdim=True)
    v = x.var(dim=axis, keepdim=True, unbiased=False)
    return (x - m) / torch.sqrt(v + eps)
def _scatter_add(tgt, idx, src, axis=0):
    return tgt.clone().index_add_(axis, idx, src)
def _segment_sum(src, seg, n):
    out = torch.zeros((n,) + src.shape[1:], dtype=src.dtype)
    return out.index_add_(0, seg, src)
def _pad(x, pw):
    flat = tuple(v for pair in reversed(pw) for v in pair)
    return torch.nn.functional.pad(x, flat)

kernel_name = 'standalone__layernorm_linear__sampling'

def setup_inputs():

    _w = (lambda a: (lambda t: t.to(torch.bfloat16) if t.is_floating_point() else t)(torch.as_tensor(a)))
    B, S, D = 1024, 4, 1024
    return {
        "x": _w((lambda *s: torch.randn(*s, dtype=torch.bfloat16) * 0.05)(B, S, D)),
        "g": _w((lambda *s: torch.randn(*s, dtype=torch.bfloat16) * 0.05)(D) + 1.0),
        "b": _w((lambda *s: torch.randn(*s, dtype=torch.bfloat16) * 0.4)(D)),
        "w": _w((lambda *s: torch.randn(*s, dtype=torch.bfloat16) * 0.05)(D, D)),
    }

def reference(x, g, b, w):
    return (_layernorm(x, axis=-1) * g + b) @ w
```

```asm
; @launch grid=(256,1,1) block=(1024,1,1) lds=137216
.amdgcn_target "amdgcn-amd-amdhsa--gfx950"
.text
.globl standalone__layernorm_linear__sampling_kernel
.p2align 8
.type standalone__layernorm_linear__sampling_kernel,@function
standalone__layernorm_linear__sampling_kernel:
    s_cmp_ge_u32 s2, 256
    s_cbranch_scc1 L_exit
    s_load_dwordx4 s[4:7], s[0:1], 0
    s_load_dwordx4 s[8:11], s[0:1], 16
    s_load_dwordx4 s[12:15], s[0:1], 32
    s_load_dwordx2 s[16:17], s[0:1], 48
    v_lshrrev_b32 v1, 6, v0
    v_and_b32 v2, 63, v0
    s_and_b32 s48, s2, 7
    s_lshl_b32 s48, s48, 2
    s_lshr_b32 s49, s2, 6
    s_add_u32 s48, s48, s49
    s_lshr_b32 s49, s2, 3
    s_and_b32 s49, s49, 7
    v_readfirstlane_b32 s50, v1
    s_mov_b32 s51, 0xffff0000
    s_lshl_b32 s52, s48, 18
    s_lshl_b32 s53, s49, 8
    s_mov_b32 s22, 0x40000
    s_mov_b32 s23, 0x00020000
    s_sub_u32 s26, 0x200000, s53
    s_mov_b32 s27, 0x00020000
    s_waitcnt lgkmcnt(0)

    s_add_u32 s20, s4, s52
    s_addc_u32 s21, s5, 0
    s_and_b32 s21, s21, 0xffff
    s_add_u32 s24, s10, s53
    s_addc_u32 s25, s11, 0
    s_and_b32 s25, s25, 0xffff
    s_add_u32 s28, s12, s52
    s_addc_u32 s29, s13, 0
    s_add_u32 s28, s28, s53
    s_addc_u32 s29, s29, 0
    s_and_b32 s29, s29, 0xffff
    s_sub_u32 s30, 0x40000, s53
    s_mov_b32 s31, 0x00020000
    s_mov_b32 s32, s6
    s_and_b32 s33, s7, 0xffff
    s_mov_b32 s34, 0x800
    s_mov_b32 s35, 0x00020000
    s_mov_b32 s36, s8
    s_and_b32 s37, s9, 0xffff
    s_mov_b32 s38, 0x800
    s_mov_b32 s39, 0x00020000
    s_mov_b32 s40, s16
    s_and_b32 s41, s17, 0xffff
    s_mov_b32 s42, 0x100000
    s_mov_b32 s43, 0x00020000
    s_mov_b32 s44, s14
    s_and_b32 s45, s15, 0xffff
    s_mov_b32 s46, 0x100
    s_mov_b32 s47, 0x00020000

    s_cmp_ge_u32 s50, 12
    s_cbranch_scc1 L_helper
    s_cmp_ge_u32 s50, 8
    s_cbranch_scc1 L_loader

    s_setprio 3
    s_lshl_b32 s57, s49, 4
    s_lshl_b32 s58, s50, 1
    s_add_u32 s57, s57, s58
    s_lshl_b32 s57, s57, 11
    v_lshlrev_b32 v3, 4, v2
    buffer_load_dwordx4 v[96:99], v3, s[20:23], s57 offen
    buffer_load_dwordx4 v[100:103], v3, s[20:23], s57 offen offset:1024
    buffer_load_dwordx4 v[104:107], v3, s[20:23], s57 offen offset:2048
    buffer_load_dwordx4 v[108:111], v3, s[20:23], s57 offen offset:3072
    s_and_b32 s54, s50, 3
    s_lshr_b32 s55, s50, 2
    v_and_b32 v3, 31, v2
    v_lshrrev_b32 v32, 5, v2
    v_lshrrev_b32 v33, 1, v3
    v_and_b32 v33, 7, v33
    v_xor_b32 v33, v33, v32
    v_lshlrev_b32 v34, 7, v3
    v_lshrrev_b32 v35, 3, v2
    v_and_b32 v35, 1, v35
    v_lshlrev_b32 v35, 5, v35
    v_lshl_add_u32 v35, v32, 3, v35
    v_and_b32 v36, 7, v2
    v_add_u32 v35, v35, v36
    s_lshl_b32 s56, s55, 4
    v_add_u32 v35, s56, v35
    v_lshlrev_b32 v7, 1, v35
    s_mov_b32 s59, 0

    v_mov_b32 v8, 0
    v_mov_b32 v9, 0
    v_mov_b32 v10, 0
    v_mov_b32 v11, 0
    buffer_load_short_d16_hi v8, v7, s[32:35], s59 offen offset:0
    buffer_load_short_d16_hi v9, v7, s[32:35], s59 offen offset:128
    buffer_load_short_d16_hi v10, v7, s[32:35], s59 offen offset:256
    buffer_load_short_d16_hi v11, v7, s[32:35], s59 offen offset:384
    s_mov_b32 s59, 512
    s_lshl_b32 s56, s55, 1
    s_add_u32 s57, s56, 0
    v_xor_b32 v36, s57, v33
    v_lshlrev_b32 v36, 4, v36
    v_add_u32 v4, v34, v36

    s_add_u32 s57, s56, 4
    v_xor_b32 v36, s57, v33
    v_lshlrev_b32 v36, 4, v36
    v_add_u32 v5, v34, v36

    v_lshrrev_b32 v32, 4, v2
    v_and_b32 v33, 1, v32
    v_lshrrev_b32 v32, 1, v32
    v_and_b32 v34, 15, v2
    v_lshrrev_b32 v35, 2, v34
    v_and_b32 v34, 3, v34
    v_lshlrev_b32 v36, 3, v32
    v_add_u32 v36, v36, v35
    v_lshlrev_b32 v36, 8, v36
    v_lshlrev_b32 v33, 5, v33
    v_lshlrev_b32 v34, 3, v34
    v_add3_u32 v36, v36, v33, v34
    s_lshl_b32 s56, s55, 12
    s_add_u32 s56, s56, 0x10000
    v_add_u32 v36, s56, v36
    v_xor_b32 v37, s54, v35
    v_lshlrev_b32 v37, 6, v37
    v_add_u32 v6, v36, v37
    v_mov_b32 v16, 0x3a800000
    v_mov_b32 v17, 0x3727c5ac

    s_waitcnt vmcnt(4)
    v_lshlrev_b32 v32, 16, v96
    v_and_b32 v33, s51, v96
    v_lshlrev_b32 v34, 16, v97
    v_and_b32 v35, s51, v97
    v_add_f32 v18, v32, v34
    v_add_f32 v20, v33, v35
    v_lshlrev_b32 v36, 16, v98
    v_and_b32 v37, s51, v98
    v_add_f32 v18, v18, v36
    v_add_f32 v20, v20, v37
    v_lshlrev_b32 v38, 16, v99
    v_and_b32 v39, s51, v99
    v_add_f32 v18, v18, v38
    v_add_f32 v20, v20, v39
    v_lshlrev_b32 v40, 16, v100
    v_and_b32 v41, s51, v100
    v_add_f32 v18, v18, v40
    v_add_f32 v20, v20, v41
    v_lshlrev_b32 v42, 16, v101
    v_and_b32 v43, s51, v101
    v_add_f32 v18, v18, v42
    v_add_f32 v20, v20, v43
    v_lshlrev_b32 v44, 16, v102
    v_and_b32 v45, s51, v102
    v_add_f32 v18, v18, v44
    v_add_f32 v20, v20, v45
    v_lshlrev_b32 v46, 16, v103
    v_and_b32 v47, s51, v103
    v_add_f32 v18, v18, v46
    v_add_f32 v20, v20, v47
    v_lshlrev_b32 v48, 16, v104
    v_and_b32 v49, s51, v104
    v_lshlrev_b32 v50, 16, v105
    v_and_b32 v51, s51, v105
    v_add_f32 v19, v48, v50
    v_add_f32 v21, v49, v51
    v_lshlrev_b32 v52, 16, v106
    v_and_b32 v53, s51, v106
    v_add_f32 v19, v19, v52
    v_add_f32 v21, v21, v53
    v_lshlrev_b32 v54, 16, v107
    v_and_b32 v55, s51, v107
    v_add_f32 v19, v19, v54
    v_add_f32 v21, v21, v55
    v_lshlrev_b32 v56, 16, v108
    v_and_b32 v57, s51, v108
    v_add_f32 v19, v19, v56
    v_add_f32 v21, v21, v57
    v_lshlrev_b32 v58, 16, v109
    v_and_b32 v59, s51, v109
    v_add_f32 v19, v19, v58
    v_add_f32 v21, v21, v59
    v_lshlrev_b32 v60, 16, v110
    v_and_b32 v61, s51, v110
    v_add_f32 v19, v19, v60
    v_add_f32 v21, v21, v61
    v_lshlrev_b32 v62, 16, v111
    v_and_b32 v63, s51, v111
    v_add_f32 v19, v19, v62
    v_add_f32 v21, v21, v63
    v_add_f32 v18, v18, v20
    v_add_f32 v19, v19, v21
    s_nop 1
    v_add_f32_dpp v18, v18, v18 quad_perm:[1,0,3,2] row_mask:0xf bank_mask:0xf
    v_add_f32_dpp v19, v19, v19 quad_perm:[1,0,3,2] row_mask:0xf bank_mask:0xf
    s_nop 1
    v_add_f32_dpp v18, v18, v18 quad_perm:[2,3,0,1] row_mask:0xf bank_mask:0xf
    v_add_f32_dpp v19, v19, v19 quad_perm:[2,3,0,1] row_mask:0xf bank_mask:0xf
    s_nop 1
    v_add_f32_dpp v18, v18, v18 row_half_mirror row_mask:0xf bank_mask:0xf
    v_add_f32_dpp v19, v19, v19 row_half_mirror row_mask:0xf bank_mask:0xf
    s_nop 1
    v_add_f32_dpp v18, v18, v18 row_mirror row_mask:0xf bank_mask:0xf
    v_add_f32_dpp v19, v19, v19 row_mirror row_mask:0xf bank_mask:0xf
    v_mov_b32 v20, v18
    v_mov_b32 v21, v19
    s_nop 1
    v_permlane16_swap_b32 v20, v18
    v_permlane16_swap_b32 v21, v19
    v_add_f32 v18, v18, v20
    v_add_f32 v19, v19, v21
    v_mov_b32 v20, v18
    v_mov_b32 v21, v19
    s_nop 1
    v_permlane32_swap_b32 v20, v18
    v_permlane32_swap_b32 v21, v19
    v_add_f32 v18, v18, v20
    v_add_f32 v19, v19, v21
    v_mul_f32 v18, v16, v18
    v_mul_f32 v19, v16, v19
    v_sub_f32 v32, v32, v18
    v_sub_f32 v48, v48, v19
    v_sub_f32 v33, v33, v18
    v_sub_f32 v49, v49, v19
    v_sub_f32 v34, v34, v18
    v_sub_f32 v50, v50, v19
    v_sub_f32 v35, v35, v18
    v_sub_f32 v51, v51, v19
    v_sub_f32 v36, v36, v18
    v_sub_f32 v52, v52, v19
    v_sub_f32 v37, v37, v18
    v_sub_f32 v53, v53, v19
    v_sub_f32 v38, v38, v18
    v_sub_f32 v54, v54, v19
    v_sub_f32 v39, v39, v18
    v_sub_f32 v55, v55, v19
    v_sub_f32 v40, v40, v18
    v_sub_f32 v56, v56, v19
    v_sub_f32 v41, v41, v18
    v_sub_f32 v57, v57, v19
    v_sub_f32 v42, v42, v18
    v_sub_f32 v58, v58, v19
    v_sub_f32 v43, v43, v18
    v_sub_f32 v59, v59, v19
    v_sub_f32 v44, v44, v18
    v_sub_f32 v60, v60, v19
    v_sub_f32 v45, v45, v18
    v_sub_f32 v61, v61, v19
    v_sub_f32 v46, v46, v18
    v_sub_f32 v62, v62, v19
    v_sub_f32 v47, v47, v18
    v_sub_f32 v63, v63, v19
    v_mul_f32 v22, v32, v32
    v_mul_f32 v23, v48, v48
    v_mul_f32 v24, v33, v33
    v_mul_f32 v25, v49, v49
    v_fmac_f32 v22, v34, v34
    v_fmac_f32 v23, v50, v50
    v_fmac_f32 v24, v35, v35
    v_fmac_f32 v25, v51, v51
    v_fmac_f32 v22, v36, v36
    v_fmac_f32 v23, v52, v52
    v_fmac_f32 v24, v37, v37
    v_fmac_f32 v25, v53, v53
    v_fmac_f32 v22, v38, v38
    v_fmac_f32 v23, v54, v54
    v_fmac_f32 v24, v39, v39
    v_fmac_f32 v25, v55, v55
    v_fmac_f32 v22, v40, v40
    v_fmac_f32 v23, v56, v56
    v_fmac_f32 v24, v41, v41
    v_fmac_f32 v25, v57, v57
    v_fmac_f32 v22, v42, v42
    v_fmac_f32 v23, v58, v58
    v_fmac_f32 v24, v43, v43
    v_fmac_f32 v25, v59, v59
    v_fmac_f32 v22, v44, v44
    v_fmac_f32 v23, v60, v60
    v_fmac_f32 v24, v45, v45
    v_fmac_f32 v25, v61, v61
    v_fmac_f32 v22, v46, v46
    v_fmac_f32 v23, v62, v62
    v_fmac_f32 v24, v47, v47
    v_fmac_f32 v25, v63, v63
    v_add_f32 v22, v22, v24
    v_add_f32 v23, v23, v25
    s_nop 1
    v_add_f32_dpp v22, v22, v22 quad_perm:[1,0,3,2] row_mask:0xf bank_mask:0xf
    v_add_f32_dpp v23, v23, v23 quad_perm:[1,0,3,2] row_mask:0xf bank_mask:0xf
    s_nop 1
    v_add_f32_dpp v22, v22, v22 quad_perm:[2,3,0,1] row_mask:0xf bank_mask:0xf
    v_add_f32_dpp v23, v23, v23 quad_perm:[2,3,0,1] row_mask:0xf bank_mask:0xf
    s_nop 1
    v_add_f32_dpp v22, v22, v22 row_half_mirror row_mask:0xf bank_mask:0xf
    v_add_f32_dpp v23, v23, v23 row_half_mirror row_mask:0xf bank_mask:0xf
    s_nop 1
    v_add_f32_dpp v22, v22, v22 row_mirror row_mask:0xf bank_mask:0xf
    v_add_f32_dpp v23, v23, v23 row_mirror row_mask:0xf bank_mask:0xf
    v_mov_b32 v24, v22
    v_mov_b32 v25, v23
    s_nop 1
    v_permlane16_swap_b32 v24, v22
    v_permlane16_swap_b32 v25, v23
    v_add_f32 v22, v22, v24
    v_add_f32 v23, v23, v25
    v_mov_b32 v24, v22
    v_mov_b32 v25, v23
    s_nop 1
    v_permlane32_swap_b32 v24, v22
    v_permlane32_swap_b32 v25, v23
    v_add_f32 v22, v22, v24
    v_add_f32 v23, v23, v25
    v_mul_f32 v22, v16, v22
    v_mul_f32 v23, v16, v23
    v_cvt_pk_bf16_f32 v22, v22, v22
    v_cvt_pk_bf16_f32 v23, v23, v23
    v_lshlrev_b32 v22, 16, v22
    v_lshlrev_b32 v23, 16, v23
    v_add_f32 v22, v17, v22
    v_add_f32 v23, v17, v23
    v_cvt_pk_bf16_f32 v22, v22, v22
    v_cvt_pk_bf16_f32 v23, v23, v23
    v_lshlrev_b32 v22, 16, v22
    v_lshlrev_b32 v23, 16, v23
    v_sqrt_f32 v22, v22
    v_sqrt_f32 v23, v23
    v_cvt_pk_bf16_f32 v18, v18, v18
    v_cvt_pk_bf16_f32 v19, v19, v19
    v_cvt_pk_bf16_f32 v22, v22, v22
    v_cvt_pk_bf16_f32 v23, v23, v23
    v_lshlrev_b32 v22, 16, v22
    v_lshlrev_b32 v23, 16, v23
    v_lshlrev_b32 v18, 16, v18
    v_lshlrev_b32 v19, 16, v19
    v_rcp_f32 v24, v22
    v_rcp_f32 v26, v23
    s_lshl_b32 s56, s50, 4
    s_add_u32 s56, s56, 133120
    v_mov_b32 v28, s56
    v_mul_f32 v25, v18, v24
    v_mul_f32 v27, v19, v26
    v_sub_f32 v25, 0, v25
    v_sub_f32 v27, 0, v27
    s_mov_b64 exec, 1
    ds_write_b128 v28, v[24:27]
    s_mov_b64 exec, -1
    s_setprio 2

    v_mov_b32 v64, 0
    v_mov_b32 v65, 0
    v_mov_b32 v66, 0
    v_mov_b32 v67, 0
    v_mov_b32 v68, 0
    v_mov_b32 v69, 0
    v_mov_b32 v70, 0
    v_mov_b32 v71, 0
    v_mov_b32 v72, 0
    v_mov_b32 v73, 0
    v_mov_b32 v74, 0
    v_mov_b32 v75, 0
    v_mov_b32 v76, 0
    v_mov_b32 v77, 0
    v_mov_b32 v78, 0
    v_mov_b32 v79, 0
    v_mov_b32 v80, 0
    v_mov_b32 v81, 0
    v_mov_b32 v82, 0
    v_mov_b32 v83, 0
    v_mov_b32 v84, 0
    v_mov_b32 v85, 0
    v_mov_b32 v86, 0
    v_mov_b32 v87, 0
    v_mov_b32 v88, 0
    v_mov_b32 v89, 0
    v_mov_b32 v90, 0
    v_mov_b32 v91, 0
    v_mov_b32 v92, 0
    v_mov_b32 v93, 0
    v_mov_b32 v94, 0
    v_mov_b32 v95, 0
    v_mov_b32 v96, 0
    v_mov_b32 v97, 0
    v_mov_b32 v98, 0
    v_mov_b32 v99, 0
    v_mov_b32 v100, 0
    v_mov_b32 v101, 0
    v_mov_b32 v102, 0
    v_mov_b32 v103, 0
    v_mov_b32 v104, 0
    v_mov_b32 v105, 0
    v_mov_b32 v106, 0
    v_mov_b32 v107, 0
    v_mov_b32 v108, 0
    v_mov_b32 v109, 0
    v_mov_b32 v110, 0
    v_mov_b32 v111, 0
    v_mov_b32 v112, 0
    v_mov_b32 v113, 0
    v_mov_b32 v114, 0
    v_mov_b32 v115, 0
    v_mov_b32 v116, 0
    v_mov_b32 v117, 0
    v_mov_b32 v118, 0
    v_mov_b32 v119, 0
    v_mov_b32 v120, 0
    v_mov_b32 v121, 0
    v_mov_b32 v122, 0
    v_mov_b32 v123, 0
    v_mov_b32 v124, 0
    v_mov_b32 v125, 0
    v_mov_b32 v126, 0
    v_mov_b32 v127, 0
    s_waitcnt lgkmcnt(0)
    s_barrier
    ds_read_b64_tr_b16 v[16:17], v6 offset:0
    ds_read_b64_tr_b16 v[18:19], v6 offset:1024
    ds_read_b128 v[32:35], v4 offset:0
    ds_read_b128 v[36:39], v4 offset:4096
    ds_read_b128 v[40:43], v4 offset:8192
    ds_read_b128 v[44:47], v4 offset:12288
    ds_read_b64_tr_b16 v[20:21], v6 offset:8192
    ds_read_b64_tr_b16 v[22:23], v6 offset:9216
    s_waitcnt vmcnt(0) lgkmcnt(6)
    v_lshlrev_b32 v12, 16, v16
    v_and_b32 v13, s51, v16
    v_mul_f32_dpp v12, v8, v12 row_newbcast:0 row_mask:0xf bank_mask:0xf
    v_mul_f32_dpp v13, v8, v13 row_newbcast:1 row_mask:0xf bank_mask:0xf
    v_cvt_pk_bf16_f32 v24, v12, v13

    v_lshlrev_b32 v14, 16, v17
    v_and_b32 v15, s51, v17
    v_mul_f32_dpp v14, v8, v14 row_newbcast:2 row_mask:0xf bank_mask:0xf
    v_mul_f32_dpp v15, v8, v15 row_newbcast:3 row_mask:0xf bank_mask:0xf
    v_cvt_pk_bf16_f32 v25, v14, v15

    v_lshlrev_b32 v12, 16, v18
    v_and_b32 v13, s51, v18
    v_mul_f32_dpp v12, v8, v12 row_newbcast:4 row_mask:0xf bank_mask:0xf
    v_mul_f32_dpp v13, v8, v13 row_newbcast:5 row_mask:0xf bank_mask:0xf
    v_cvt_pk_bf16_f32 v26, v12, v13

    v_lshlrev_b32 v14, 16, v19
    v_and_b32 v15, s51, v19
    v_mul_f32_dpp v14, v8, v14 row_newbcast:6 row_mask:0xf bank_mask:0xf
    v_mul_f32_dpp v15, v8, v15 row_newbcast:7 row_mask:0xf bank_mask:0xf
    v_cvt_pk_bf16_f32 v27, v14, v15

    s_mov_b32 s58, 0
    s_cmp_eq_u32 s55, 0
    s_cselect_b64 vcc, -1, 0
L_cloop:
    s_waitcnt lgkmcnt(0)
    v_mfma_f32_32x32x16_bf16 v[64:79], v[24:27], v[32:35], v[64:79]
    ds_read_b128 v[48:51], v5 offset:0
    ds_read_b128 v[52:55], v5 offset:4096
    v_mfma_f32_32x32x16_bf16 v[80:95], v[24:27], v[36:39], v[80:95]
    ds_read_b128 v[56:59], v5 offset:8192
    ds_read_b128 v[60:63], v5 offset:12288
    v_mfma_f32_32x32x16_bf16 v[96:111], v[24:27], v[40:43], v[96:111]
    ds_read_b64_tr_b16 v[16:17], v6 offset:16384
    ds_read_b64_tr_b16 v[18:19], v6 offset:17408
    v_mfma_f32_32x32x16_bf16 v[112:127], v[24:27], v[44:47], v[112:127]
    v_lshlrev_b32 v12, 16, v20
    v_and_b32 v13, s51, v20
    v_mul_f32_dpp v12, v8, v12 row_newbcast:8 row_mask:0xf bank_mask:0xf
    v_mul_f32_dpp v13, v8, v13 row_newbcast:9 row_mask:0xf bank_mask:0xf
    v_cvt_pk_bf16_f32 v28, v12, v13

    v_lshlrev_b32 v14, 16, v21
    v_and_b32 v15, s51, v21
    v_mul_f32_dpp v14, v8, v14 row_newbcast:10 row_mask:0xf bank_mask:0xf
    v_mul_f32_dpp v15, v8, v15 row_newbcast:11 row_mask:0xf bank_mask:0xf
    v_cvt_pk_bf16_f32 v29, v14, v15

    v_lshlrev_b32 v12, 16, v22
    v_and_b32 v13, s51, v22
    v_mul_f32_dpp v12, v8, v12 row_newbcast:12 row_mask:0xf bank_mask:0xf
    v_mul_f32_dpp v13, v8, v13 row_newbcast:13 row_mask:0xf bank_mask:0xf
    v_cvt_pk_bf16_f32 v30, v12, v13

    v_lshlrev_b32 v14, 16, v23
    v_and_b32 v15, s51, v23
    v_mul_f32_dpp v14, v8, v14 row_newbcast:14 row_mask:0xf bank_mask:0xf
    v_mul_f32_dpp v15, v8, v15 row_newbcast:15 row_mask:0xf bank_mask:0xf
    v_cvt_pk_bf16_f32 v31, v14, v15

    buffer_load_short_d16_hi v8, v7, s[32:35], s59 offen offset:0
    s_waitcnt vmcnt(3) lgkmcnt(0)
    v_mfma_f32_32x32x16_bf16 v[64:79], v[28:31], v[48:51], v[64:79]
    ds_read_b128 v[32:35], v4 offset:16384
    ds_read_b128 v[36:39], v4 offset:20480
    v_mfma_f32_32x32x16_bf16 v[80:95], v[28:31], v[52:55], v[80:95]
    ds_read_b128 v[40:43], v4 offset:24576
    ds_read_b128 v[44:47], v4 offset:28672
    v_mfma_f32_32x32x16_bf16 v[96:111], v[28:31], v[56:59], v[96:111]
    ds_read_b64_tr_b16 v[20:21], v6 offset:24576
    ds_read_b64_tr_b16 v[22:23], v6 offset:25600
    v_mfma_f32_32x32x16_bf16 v[112:127], v[28:31], v[60:63], v[112:127]
    s_cbranch_vccz L_be0
    s_barrier
L_be0:
    v_lshlrev_b32 v12, 16, v16
    v_and_b32 v13, s51, v16
    v_mul_f32_dpp v12, v9, v12 row_newbcast:0 row_mask:0xf bank_mask:0xf
    v_mul_f32_dpp v13, v9, v13 row_newbcast:1 row_mask:0xf bank_mask:0xf
    v_cvt_pk_bf16_f32 v24, v12, v13

    v_lshlrev_b32 v14, 16, v17
    v_and_b32 v15, s51, v17
    v_mul_f32_dpp v14, v9, v14 row_newbcast:2 row_mask:0xf bank_mask:0xf
    v_mul_f32_dpp v15, v9, v15 row_newbcast:3 row_mask:0xf bank_mask:0xf
    v_cvt_pk_bf16_f32 v25, v14, v15

    v_lshlrev_b32 v12, 16, v18
    v_and_b32 v13, s51, v18
    v_mul_f32_dpp v12, v9, v12 row_newbcast:4 row_mask:0xf bank_mask:0xf
    v_mul_f32_dpp v13, v9, v13 row_newbcast:5 row_mask:0xf bank_mask:0xf
    v_cvt_pk_bf16_f32 v26, v12, v13

    v_lshlrev_b32 v14, 16, v19
    v_and_b32 v15, s51, v19
    v_mul_f32_dpp v14, v9, v14 row_newbcast:6 row_mask:0xf bank_mask:0xf
    v_mul_f32_dpp v15, v9, v15 row_newbcast:7 row_mask:0xf bank_mask:0xf
    v_cvt_pk_bf16_f32 v27, v14, v15

    s_cbranch_vccnz L_bl0
    s_barrier
L_bl0:
    s_waitcnt lgkmcnt(0)
    v_mfma_f32_32x32x16_bf16 v[64:79], v[24:27], v[32:35], v[64:79]
    ds_read_b128 v[48:51], v5 offset:16384
    ds_read_b128 v[52:55], v5 offset:20480
    v_mfma_f32_32x32x16_bf16 v[80:95], v[24:27], v[36:39], v[80:95]
    ds_read_b128 v[56:59], v5 offset:24576
    ds_read_b128 v[60:63], v5 offset:28672
    v_mfma_f32_32x32x16_bf16 v[96:111], v[24:27], v[40:43], v[96:111]
    ds_read_b64_tr_b16 v[16:17], v6 offset:32768
    ds_read_b64_tr_b16 v[18:19], v6 offset:33792
    v_mfma_f32_32x32x16_bf16 v[112:127], v[24:27], v[44:47], v[112:127]
    v_lshlrev_b32 v12, 16, v20
    v_and_b32 v13, s51, v20
    v_mul_f32_dpp v12, v9, v12 row_newbcast:8 row_mask:0xf bank_mask:0xf
    v_mul_f32_dpp v13, v9, v13 row_newbcast:9 row_mask:0xf bank_mask:0xf
    v_cvt_pk_bf16_f32 v28, v12, v13

    v_lshlrev_b32 v14, 16, v21
    v_and_b32 v15, s51, v21
    v_mul_f32_dpp v14, v9, v14 row_newbcast:10 row_mask:0xf bank_mask:0xf
    v_mul_f32_dpp v15, v9, v15 row_newbcast:11 row_mask:0xf bank_mask:0xf
    v_cvt_pk_bf16_f32 v29, v14, v15

    v_lshlrev_b32 v12, 16, v22
    v_and_b32 v13, s51, v22
    v_mul_f32_dpp v12, v9, v12 row_newbcast:12 row_mask:0xf bank_mask:0xf
    v_mul_f32_dpp v13, v9, v13 row_newbcast:13 row_mask:0xf bank_mask:0xf
    v_cvt_pk_bf16_f32 v30, v12, v13

    v_lshlrev_b32 v14, 16, v23
    v_and_b32 v15, s51, v23
    v_mul_f32_dpp v14, v9, v14 row_newbcast:14 row_mask:0xf bank_mask:0xf
    v_mul_f32_dpp v15, v9, v15 row_newbcast:15 row_mask:0xf bank_mask:0xf
    v_cvt_pk_bf16_f32 v31, v14, v15

    buffer_load_short_d16_hi v9, v7, s[32:35], s59 offen offset:128
    s_waitcnt vmcnt(3) lgkmcnt(0)
    v_mfma_f32_32x32x16_bf16 v[64:79], v[28:31], v[48:51], v[64:79]
    ds_read_b128 v[32:35], v4 offset:32768
    ds_read_b128 v[36:39], v4 offset:36864
    v_mfma_f32_32x32x16_bf16 v[80:95], v[28:31], v[52:55], v[80:95]
    ds_read_b128 v[40:43], v4 offset:40960
    ds_read_b128 v[44:47], v4 offset:45056
    v_mfma_f32_32x32x16_bf16 v[96:111], v[28:31], v[56:59], v[96:111]
    ds_read_b64_tr_b16 v[20:21], v6 offset:40960
    ds_read_b64_tr_b16 v[22:23], v6 offset:41984
    v_mfma_f32_32x32x16_bf16 v[112:127], v[28:31], v[60:63], v[112:127]
    s_cbranch_vccz L_be1
    s_barrier
L_be1:
    v_lshlrev_b32 v12, 16, v16
    v_and_b32 v13, s51, v16
    v_mul_f32_dpp v12, v10, v12 row_newbcast:0 row_mask:0xf bank_mask:0xf
    v_mul_f32_dpp v13, v10, v13 row_newbcast:1 row_mask:0xf bank_mask:0xf
    v_cvt_pk_bf16_f32 v24, v12, v13

    v_lshlrev_b32 v14, 16, v17
    v_and_b32 v15, s51, v17
    v_mul_f32_dpp v14, v10, v14 row_newbcast:2 row_mask:0xf bank_mask:0xf
    v_mul_f32_dpp v15, v10, v15 row_newbcast:3 row_mask:0xf bank_mask:0xf
    v_cvt_pk_bf16_f32 v25, v14, v15

    v_lshlrev_b32 v12, 16, v18
    v_and_b32 v13, s51, v18
    v_mul_f32_dpp v12, v10, v12 row_newbcast:4 row_mask:0xf bank_mask:0xf
    v_mul_f32_dpp v13, v10, v13 row_newbcast:5 row_mask:0xf bank_mask:0xf
    v_cvt_pk_bf16_f32 v26, v12, v13

    v_lshlrev_b32 v14, 16, v19
    v_and_b32 v15, s51, v19
    v_mul_f32_dpp v14, v10, v14 row_newbcast:6 row_mask:0xf bank_mask:0xf
    v_mul_f32_dpp v15, v10, v15 row_newbcast:7 row_mask:0xf bank_mask:0xf
    v_cvt_pk_bf16_f32 v27, v14, v15

    s_cbranch_vccnz L_bl1
    s_barrier
L_bl1:
    s_waitcnt lgkmcnt(0)
    v_mfma_f32_32x32x16_bf16 v[64:79], v[24:27], v[32:35], v[64:79]
    ds_read_b128 v[48:51], v5 offset:32768
    ds_read_b128 v[52:55], v5 offset:36864
    v_mfma_f32_32x32x16_bf16 v[80:95], v[24:27], v[36:39], v[80:95]
    ds_read_b128 v[56:59], v5 offset:40960
    ds_read_b128 v[60:63], v5 offset:45056
    v_mfma_f32_32x32x16_bf16 v[96:111], v[24:27], v[40:43], v[96:111]
    ds_read_b64_tr_b16 v[16:17], v6 offset:49152
    ds_read_b64_tr_b16 v[18:19], v6 offset:50176
    v_mfma_f32_32x32x16_bf16 v[112:127], v[24:27], v[44:47], v[112:127]
    v_lshlrev_b32 v12, 16, v20
    v_and_b32 v13, s51, v20
    v_mul_f32_dpp v12, v10, v12 row_newbcast:8 row_mask:0xf bank_mask:0xf
    v_mul_f32_dpp v13, v10, v13 row_newbcast:9 row_mask:0xf bank_mask:0xf
    v_cvt_pk_bf16_f32 v28, v12, v13

    v_lshlrev_b32 v14, 16, v21
    v_and_b32 v15, s51, v21
    v_mul_f32_dpp v14, v10, v14 row_newbcast:10 row_mask:0xf bank_mask:0xf
    v_mul_f32_dpp v15, v10, v15 row_newbcast:11 row_mask:0xf bank_mask:0xf
    v_cvt_pk_bf16_f32 v29, v14, v15

    v_lshlrev_b32 v12, 16, v22
    v_and_b32 v13, s51, v22
    v_mul_f32_dpp v12, v10, v12 row_newbcast:12 row_mask:0xf bank_mask:0xf
    v_mul_f32_dpp v13, v10, v13 row_newbcast:13 row_mask:0xf bank_mask:0xf
    v_cvt_pk_bf16_f32 v30, v12, v13

    v_lshlrev_b32 v14, 16, v23
    v_and_b32 v15, s51, v23
    v_mul_f32_dpp v14, v10, v14 row_newbcast:14 row_mask:0xf bank_mask:0xf
    v_mul_f32_dpp v15, v10, v15 row_newbcast:15 row_mask:0xf bank_mask:0xf
    v_cvt_pk_bf16_f32 v31, v14, v15

    buffer_load_short_d16_hi v10, v7, s[32:35], s59 offen offset:256
    s_waitcnt vmcnt(3) lgkmcnt(0)
    v_mfma_f32_32x32x16_bf16 v[64:79], v[28:31], v[48:51], v[64:79]
    ds_read_b128 v[32:35], v4 offset:49152
    ds_read_b128 v[36:39], v4 offset:53248
    v_mfma_f32_32x32x16_bf16 v[80:95], v[28:31], v[52:55], v[80:95]
    ds_read_b128 v[40:43], v4 offset:57344
    ds_read_b128 v[44:47], v4 offset:61440
    v_mfma_f32_32x32x16_bf16 v[96:111], v[28:31], v[56:59], v[96:111]
    ds_read_b64_tr_b16 v[20:21], v6 offset:57344
    ds_read_b64_tr_b16 v[22:23], v6 offset:58368
    v_mfma_f32_32x32x16_bf16 v[112:127], v[28:31], v[60:63], v[112:127]
    s_cbranch_vccz L_be2
    s_barrier
L_be2:
    v_lshlrev_b32 v12, 16, v16
    v_and_b32 v13, s51, v16
    v_mul_f32_dpp v12, v11, v12 row_newbcast:0 row_mask:0xf bank_mask:0xf
    v_mul_f32_dpp v13, v11, v13 row_newbcast:1 row_mask:0xf bank_mask:0xf
    v_cvt_pk_bf16_f32 v24, v12, v13

    v_lshlrev_b32 v14, 16, v17
    v_and_b32 v15, s51, v17
    v_mul_f32_dpp v14, v11, v14 row_newbcast:2 row_mask:0xf bank_mask:0xf
    v_mul_f32_dpp v15, v11, v15 row_newbcast:3 row_mask:0xf bank_mask:0xf
    v_cvt_pk_bf16_f32 v25, v14, v15

    v_lshlrev_b32 v12, 16, v18
    v_and_b32 v13, s51, v18
    v_mul_f32_dpp v12, v11, v12 row_newbcast:4 row_mask:0xf bank_mask:0xf
    v_mul_f32_dpp v13, v11, v13 row_newbcast:5 row_mask:0xf bank_mask:0xf
    v_cvt_pk_bf16_f32 v26, v12, v13

    v_lshlrev_b32 v14, 16, v19
    v_and_b32 v15, s51, v19
    v_mul_f32_dpp v14, v11, v14 row_newbcast:6 row_mask:0xf bank_mask:0xf
    v_mul_f32_dpp v15, v11, v15 row_newbcast:7 row_mask:0xf bank_mask:0xf
    v_cvt_pk_bf16_f32 v27, v14, v15

    s_cbranch_vccnz L_bl2
    s_barrier
L_bl2:
    s_waitcnt lgkmcnt(0)
    v_mfma_f32_32x32x16_bf16 v[64:79], v[24:27], v[32:35], v[64:79]
    ds_read_b128 v[48:51], v5 offset:49152
    ds_read_b128 v[52:55], v5 offset:53248
    v_mfma_f32_32x32x16_bf16 v[80:95], v[24:27], v[36:39], v[80:95]
    ds_read_b128 v[56:59], v5 offset:57344
    ds_read_b128 v[60:63], v5 offset:61440
    v_mfma_f32_32x32x16_bf16 v[96:111], v[24:27], v[40:43], v[96:111]
    ds_read_b64_tr_b16 v[16:17], v6 offset:0
    ds_read_b64_tr_b16 v[18:19], v6 offset:1024
    v_mfma_f32_32x32x16_bf16 v[112:127], v[24:27], v[44:47], v[112:127]
    v_lshlrev_b32 v12, 16, v20
    v_and_b32 v13, s51, v20
    v_mul_f32_dpp v12, v11, v12 row_newbcast:8 row_mask:0xf bank_mask:0xf
    v_mul_f32_dpp v13, v11, v13 row_newbcast:9 row_mask:0xf bank_mask:0xf
    v_cvt_pk_bf16_f32 v28, v12, v13

    v_lshlrev_b32 v14, 16, v21
    v_and_b32 v15, s51, v21
    v_mul_f32_dpp v14, v11, v14 row_newbcast:10 row_mask:0xf bank_mask:0xf
    v_mul_f32_dpp v15, v11, v15 row_newbcast:11 row_mask:0xf bank_mask:0xf
    v_cvt_pk_bf16_f32 v29, v14, v15

    v_lshlrev_b32 v12, 16, v22
    v_and_b32 v13, s51, v22
    v_mul_f32_dpp v12, v11, v12 row_newbcast:12 row_mask:0xf bank_mask:0xf
    v_mul_f32_dpp v13, v11, v13 row_newbcast:13 row_mask:0xf bank_mask:0xf
    v_cvt_pk_bf16_f32 v30, v12, v13

    v_lshlrev_b32 v14, 16, v23
    v_and_b32 v15, s51, v23
    v_mul_f32_dpp v14, v11, v14 row_newbcast:14 row_mask:0xf bank_mask:0xf
    v_mul_f32_dpp v15, v11, v15 row_newbcast:15 row_mask:0xf bank_mask:0xf
    v_cvt_pk_bf16_f32 v31, v14, v15

    buffer_load_short_d16_hi v11, v7, s[32:35], s59 offen offset:384
    s_waitcnt vmcnt(3) lgkmcnt(0)
    v_mfma_f32_32x32x16_bf16 v[64:79], v[28:31], v[48:51], v[64:79]
    ds_read_b128 v[32:35], v4 offset:0
    ds_read_b128 v[36:39], v4 offset:4096
    v_mfma_f32_32x32x16_bf16 v[80:95], v[28:31], v[52:55], v[80:95]
    ds_read_b128 v[40:43], v4 offset:8192
    ds_read_b128 v[44:47], v4 offset:12288
    v_mfma_f32_32x32x16_bf16 v[96:111], v[28:31], v[56:59], v[96:111]
    ds_read_b64_tr_b16 v[20:21], v6 offset:8192
    ds_read_b64_tr_b16 v[22:23], v6 offset:9216
    v_mfma_f32_32x32x16_bf16 v[112:127], v[28:31], v[60:63], v[112:127]
    s_add_u32 s59, s59, 512
    s_add_u32 s58, s58, 1
    s_cmp_lt_u32 s58, 4
    s_cbranch_scc0 L_cdone
    s_cbranch_vccz L_be3
    s_barrier
L_be3:
    v_lshlrev_b32 v12, 16, v16
    v_and_b32 v13, s51, v16
    v_mul_f32_dpp v12, v8, v12 row_newbcast:0 row_mask:0xf bank_mask:0xf
    v_mul_f32_dpp v13, v8, v13 row_newbcast:1 row_mask:0xf bank_mask:0xf
    v_cvt_pk_bf16_f32 v24, v12, v13

    v_lshlrev_b32 v14, 16, v17
    v_and_b32 v15, s51, v17
    v_mul_f32_dpp v14, v8, v14 row_newbcast:2 row_mask:0xf bank_mask:0xf
    v_mul_f32_dpp v15, v8, v15 row_newbcast:3 row_mask:0xf bank_mask:0xf
    v_cvt_pk_bf16_f32 v25, v14, v15

    v_lshlrev_b32 v12, 16, v18
    v_and_b32 v13, s51, v18
    v_mul_f32_dpp v12, v8, v12 row_newbcast:4 row_mask:0xf bank_mask:0xf
    v_mul_f32_dpp v13, v8, v13 row_newbcast:5 row_mask:0xf bank_mask:0xf
    v_cvt_pk_bf16_f32 v26, v12, v13

    v_lshlrev_b32 v14, 16, v19
    v_and_b32 v15, s51, v19
    v_mul_f32_dpp v14, v8, v14 row_newbcast:6 row_mask:0xf bank_mask:0xf
    v_mul_f32_dpp v15, v8, v15 row_newbcast:7 row_mask:0xf bank_mask:0xf
    v_cvt_pk_bf16_f32 v27, v14, v15

    s_cbranch_vccnz L_bl3
    s_barrier
L_bl3:
    s_branch L_cloop
L_cdone:
    v_lshlrev_b32 v3, 4, v2
    s_lshl_b32 s56, s54, 13
    s_lshl_b32 s57, s55, 16
    s_add_u32 s56, s56, s57
    s_xor_b32 s57, s56, 0x10000
    s_waitcnt vmcnt(0) lgkmcnt(0)
    v_add_u32 v53, s56, v3
    v_add_u32 v54, s57, v3
    v_and_b32 v3, 31, v2
    v_lshrrev_b32 v55, 5, v2
    v_lshlrev_b32 v56, 2, v3
    s_lshl_b32 s56, s55, 8
    s_add_u32 s56, s56, 131072
    v_add_u32 v56, s56, v56
    s_lshl_b32 s56, s54, 7
    s_add_u32 s56, s56, 131072
    v_lshlrev_b32 v57, 4, v55
    v_add_u32 v57, s56, v57
    s_cbranch_vccz L_kp1

    ds_write_b128 v53, v[96:99] offset:0
    ds_write_b128 v53, v[100:103] offset:1024
    ds_write_b128 v53, v[104:107] offset:2048
    ds_write_b128 v53, v[108:111] offset:3072
    ds_write_b128 v53, v[112:115] offset:4096
    ds_write_b128 v53, v[116:119] offset:5120
    ds_write_b128 v53, v[120:123] offset:6144
    ds_write_b128 v53, v[124:127] offset:7168
    s_branch L_xdone
L_kp1:
    ds_write_b128 v53, v[64:67] offset:0
    ds_write_b128 v53, v[68:71] offset:1024
    ds_write_b128 v53, v[72:75] offset:2048
    ds_write_b128 v53, v[76:79] offset:3072
    ds_write_b128 v53, v[80:83] offset:4096
    ds_write_b128 v53, v[84:87] offset:5120
    ds_write_b128 v53, v[88:91] offset:6144
    ds_write_b128 v53, v[92:95] offset:7168
L_xdone:
    v_and_b32 v58, 7, v3
    v_lshlrev_b32 v58, 1, v58
    v_lshlrev_b32 v59, 8, v3
    s_lshl_b32 s56, s55, 14
    s_add_u32 s56, s56, 32768
    v_add_u32 v59, s56, v59
    s_lshl_b32 s56, s54, 3
    v_add_u32 v60, s56, v55

    v_add_u32 v61, 0, v60
    v_xor_b32 v61, v61, v58
    v_lshl_add_u32 v8, v61, 3, v59

    v_add_u32 v61, 2, v60
    v_xor_b32 v61, v61, v58
    v_lshl_add_u32 v9, v61, 3, v59

    v_add_u32 v61, 4, v60
    v_xor_b32 v61, v61, v58
    v_lshl_add_u32 v10, v61, 3, v59

    v_add_u32 v61, 6, v60
    v_xor_b32 v61, v61, v58
    v_lshl_add_u32 v11, v61, 3, v59

    s_waitcnt lgkmcnt(0)
    s_barrier
    ds_read_b32 v4, v56 offset:1024
    ds_read_b32 v12, v56 offset:1536
    ds_read_b32 v6, v56 offset:1152
    ds_read_b32 v14, v56 offset:1664
    ds_read_b128 v[16:19], v57 offset:0
    ds_read_b128 v[32:35], v57 offset:512
    ds_read_b128 v[20:23], v57 offset:32
    ds_read_b128 v[36:39], v57 offset:544
    ds_read_b128 v[24:27], v57 offset:64
    ds_read_b128 v[40:43], v57 offset:576
    ds_read_b128 v[28:31], v57 offset:96
    ds_read_b128 v[44:47], v57 offset:608
    s_cbranch_vccz L_kp1r
    ds_read_b128 v[96:99], v54 offset:0
    ds_read_b128 v[100:103], v54 offset:1024
    ds_read_b128 v[104:107], v54 offset:2048
    ds_read_b128 v[108:111], v54 offset:3072
    ds_read_b128 v[112:115], v54 offset:4096
    ds_read_b128 v[116:119], v54 offset:5120
    ds_read_b128 v[120:123], v54 offset:6144
    ds_read_b128 v[124:127], v54 offset:7168
    s_branch L_rdone
L_kp1r:
    ds_read_b128 v[64:67], v54 offset:0
    ds_read_b128 v[68:71], v54 offset:1024
    ds_read_b128 v[72:75], v54 offset:2048
    ds_read_b128 v[76:79], v54 offset:3072
    ds_read_b128 v[80:83], v54 offset:4096
    ds_read_b128 v[84:87], v54 offset:5120
    ds_read_b128 v[88:91], v54 offset:6144
    ds_read_b128 v[92:95], v54 offset:7168
L_rdone:
    s_waitcnt lgkmcnt(7)
    v_pk_add_f32 v[64:65], v[64:65], v[96:97]
    v_pk_add_f32 v[66:67], v[66:67], v[98:99]
    v_pk_fma_f32 v[48:49], v[12:13], v[16:17], v[32:33] op_sel_hi:[0,1,1]
    v_pk_fma_f32 v[50:51], v[12:13], v[18:19], v[34:35] op_sel_hi:[0,1,1]
    v_pk_fma_f32 v[48:49], v[4:5], v[64:65], v[48:49] op_sel_hi:[0,1,1]
    v_pk_fma_f32 v[50:51], v[4:5], v[66:67], v[50:51] op_sel_hi:[0,1,1]
    v_cvt_pk_bf16_f32 v64, v48, v49
    v_cvt_pk_bf16_f32 v65, v50, v51
    ds_write_b64 v8, v[64:65] offset:0
    s_waitcnt lgkmcnt(7)
    v_pk_add_f32 v[68:69], v[68:69], v[100:101]
    v_pk_add_f32 v[70:71], v[70:71], v[102:103]
    v_pk_fma_f32 v[48:49], v[12:13], v[20:21], v[36:37] op_sel_hi:[0,1,1]
    v_pk_fma_f32 v[50:51], v[12:13], v[22:23], v[38:39] op_sel_hi:[0,1,1]
    v_pk_fma_f32 v[48:49], v[4:5], v[68:69], v[48:49] op_sel_hi:[0,1,1]
    v_pk_fma_f32 v[50:51], v[4:5], v[70:71], v[50:51] op_sel_hi:[0,1,1]
    v_cvt_pk_bf16_f32 v68, v48, v49
    v_cvt_pk_bf16_f32 v69, v50, v51
    ds_write_b64 v9, v[68:69] offset:0
    s_waitcnt lgkmcnt(7)
    v_pk_add_f32 v[72:73], v[72:73], v[104:105]
    v_pk_add_f32 v[74:75], v[74:75], v[106:107]
    v_pk_fma_f32 v[48:49], v[12:13], v[24:25], v[40:41] op_sel_hi:[0,1,1]
    v_pk_fma_f32 v[50:51], v[12:13], v[26:27], v[42:43] op_sel_hi:[0,1,1]
    v_pk_fma_f32 v[48:49], v[4:5], v[72:73], v[48:49] op_sel_hi:[0,1,1]
    v_pk_fma_f32 v[50:51], v[4:5], v[74:75], v[50:51] op_sel_hi:[0,1,1]
    v_cvt_pk_bf16_f32 v72, v48, v49
    v_cvt_pk_bf16_f32 v73, v50, v51
    ds_write_b64 v10, v[72:73] offset:0
    s_waitcnt lgkmcnt(7)
    v_pk_add_f32 v[76:77], v[76:77], v[108:109]
    v_pk_add_f32 v[78:79], v[78:79], v[110:111]
    v_pk_fma_f32 v[48:49], v[12:13], v[28:29], v[44:45] op_sel_hi:[0,1,1]
    v_pk_fma_f32 v[50:51], v[12:13], v[30:31], v[46:47] op_sel_hi:[0,1,1]
    v_pk_fma_f32 v[48:49], v[4:5], v[76:77], v[48:49] op_sel_hi:[0,1,1]
    v_pk_fma_f32 v[50:51], v[4:5], v[78:79], v[50:51] op_sel_hi:[0,1,1]
    v_cvt_pk_bf16_f32 v76, v48, v49
    v_cvt_pk_bf16_f32 v77, v50, v51
    ds_write_b64 v11, v[76:77] offset:0
    s_waitcnt lgkmcnt(7)
    v_pk_add_f32 v[80:81], v[80:81], v[112:113]
    v_pk_add_f32 v[82:83], v[82:83], v[114:115]
    v_pk_fma_f32 v[48:49], v[14:15], v[16:17], v[32:33] op_sel_hi:[0,1,1]
    v_pk_fma_f32 v[50:51], v[14:15], v[18:19], v[34:35] op_sel_hi:[0,1,1]
    v_pk_fma_f32 v[48:49], v[6:7], v[80:81], v[48:49] op_sel_hi:[0,1,1]
    v_pk_fma_f32 v[50:51], v[6:7], v[82:83], v[50:51] op_sel_hi:[0,1,1]
    v_cvt_pk_bf16_f32 v80, v48, v49
    v_cvt_pk_bf16_f32 v81, v50, v51
    ds_write_b64 v8, v[80:81] offset:8192
    s_waitcnt lgkmcnt(7)
    v_pk_add_f32 v[84:85], v[84:85], v[116:117]
    v_pk_add_f32 v[86:87], v[86:87], v[118:119]
    v_pk_fma_f32 v[48:49], v[14:15], v[20:21], v[36:37] op_sel_hi:[0,1,1]
    v_pk_fma_f32 v[50:51], v[14:15], v[22:23], v[38:39] op_sel_hi:[0,1,1]
    v_pk_fma_f32 v[48:49], v[6:7], v[84:85], v[48:49] op_sel_hi:[0,1,1]
    v_pk_fma_f32 v[50:51], v[6:7], v[86:87], v[50:51] op_sel_hi:[0,1,1]
    v_cvt_pk_bf16_f32 v84, v48, v49
    v_cvt_pk_bf16_f32 v85, v50, v51
    ds_write_b64 v9, v[84:85] offset:8192
    s_waitcnt lgkmcnt(7)
    v_pk_add_f32 v[88:89], v[88:89], v[120:121]
    v_pk_add_f32 v[90:91], v[90:91], v[122:123]
    v_pk_fma_f32 v[48:49], v[14:15], v[24:25], v[40:41] op_sel_hi:[0,1,1]
    v_pk_fma_f32 v[50:51], v[14:15], v[26:27], v[42:43] op_sel_hi:[0,1,1]
    v_pk_fma_f32 v[48:49], v[6:7], v[88:89], v[48:49] op_sel_hi:[0,1,1]
    v_pk_fma_f32 v[50:51], v[6:7], v[90:91], v[50:51] op_sel_hi:[0,1,1]
    v_cvt_pk_bf16_f32 v88, v48, v49
    v_cvt_pk_bf16_f32 v89, v50, v51
    ds_write_b64 v10, v[88:89] offset:8192
    s_waitcnt lgkmcnt(7)
    v_pk_add_f32 v[92:93], v[92:93], v[124:125]
    v_pk_add_f32 v[94:95], v[94:95], v[126:127]
    v_pk_fma_f32 v[48:49], v[14:15], v[28:29], v[44:45] op_sel_hi:[0,1,1]
    v_pk_fma_f32 v[50:51], v[14:15], v[30:31], v[46:47] op_sel_hi:[0,1,1]
    v_pk_fma_f32 v[48:49], v[6:7], v[92:93], v[48:49] op_sel_hi:[0,1,1]
    v_pk_fma_f32 v[50:51], v[6:7], v[94:95], v[50:51] op_sel_hi:[0,1,1]
    v_cvt_pk_bf16_f32 v92, v48, v49
    v_cvt_pk_bf16_f32 v93, v50, v51
    ds_write_b64 v11, v[92:93] offset:8192
    s_branch L_store
L_loader:
    s_sub_u32 s54, s50, 8
    v_lshrrev_b32 v3, 3, v2
    v_lshrrev_b32 v4, 4, v2
    v_and_b32 v5, 7, v2
    s_lshl_b32 s55, s54, 5
    v_add_u32 v6, s55, v3
    v_lshlrev_b32 v6, 11, v6
    v_xor_b32 v7, v5, v4
    v_lshl_add_u32 v8, v7, 4, v6
    v_add_u32 v10, 0x8000, v8
    v_xor_b32 v7, 4, v7
    v_lshl_add_u32 v9, v7, 4, v6
    v_add_u32 v9, 0x4000, v9
    v_add_u32 v11, 0x8000, v9
    s_lshl_b32 s56, s54, 12
    v_lshrrev_b32 v16, 2, v2
    v_and_b32 v16, 3, v16
    v_xor_b32 v16, v16, v4
    v_lshlrev_b32 v16, 6, v16
    v_and_b32 v17, 3, v2
    v_lshl_add_u32 v16, v17, 4, v16
    s_lshl_b32 s55, s54, 4
    v_add_u32 v17, s55, v4
    v_lshl_add_u32 v12, v17, 11, v16
    v_add_u32 v13, 0x2000, v12
    v_add_u32 v14, 0x4000, v12
    v_add_u32 v15, 0x6000, v12
    s_mov_b32 s57, 0
    s_mov_b32 s58, 0

    s_add_u32 m0, s56, 65536
    s_nop 0
    buffer_load_dwordx4 v12, s[24:27], s58 offen lds
    s_add_u32 m0, s56, 0
    s_nop 0
    buffer_load_dwordx4 v8, s[20:23], s57 offen lds
    s_add_u32 m0, s56, 66560
    s_nop 0
    buffer_load_dwordx4 v13, s[24:27], s58 offen lds
    s_add_u32 m0, s56, 1024
    s_nop 0
    buffer_load_dwordx4 v9, s[20:23], s57 offen lds
    s_add_u32 m0, s56, 67584
    s_nop 0
    buffer_load_dwordx4 v14, s[24:27], s58 offen lds
    s_add_u32 m0, s56, 2048
    s_nop 0
    buffer_load_dwordx4 v10, s[20:23], s57 offen lds
    s_add_u32 m0, s56, 68608
    s_nop 0
    buffer_load_dwordx4 v15, s[24:27], s58 offen lds
    s_add_u32 m0, s56, 3072
    s_add_u32 s66, s57, 128
    buffer_load_dwordx4 v11, s[20:23], s57 offen lds
    s_add_u32 s58, s58, 0x20000
    s_cmp_ge_u32 s66, 0x800
    s_cselect_b32 s57, 0x40000000, s66

    s_add_u32 m0, s56, 81920
    s_nop 0
    buffer_load_dwordx4 v12, s[24:27], s58 offen lds
    s_add_u32 m0, s56, 16384
    s_nop 0
    buffer_load_dwordx4 v8, s[20:23], s57 offen lds
    s_add_u32 m0, s56, 82944
    s_nop 0
    buffer_load_dwordx4 v13, s[24:27], s58 offen lds
    s_add_u32 m0, s56, 17408
    s_nop 0
    buffer_load_dwordx4 v9, s[20:23], s57 offen lds
    s_add_u32 m0, s56, 83968
    s_nop 0
    buffer_load_dwordx4 v14, s[24:27], s58 offen lds
    s_add_u32 m0, s56, 18432
    s_nop 0
    buffer_load_dwordx4 v10, s[20:23], s57 offen lds
    s_add_u32 m0, s56, 84992
    s_nop 0
    buffer_load_dwordx4 v15, s[24:27], s58 offen lds
    s_add_u32 m0, s56, 19456
    s_add_u32 s66, s57, 128
    buffer_load_dwordx4 v11, s[20:23], s57 offen lds
    s_add_u32 s58, s58, 0x20000
    s_cmp_ge_u32 s66, 0x800
    s_cselect_b32 s57, 0x40000000, s66

    s_add_u32 m0, s56, 98304
    s_nop 0
    buffer_load_dwordx4 v12, s[24:27], s58 offen lds
    s_add_u32 m0, s56, 32768
    s_nop 0
    buffer_load_dwordx4 v8, s[20:23], s57 offen lds
    s_add_u32 m0, s56, 99328
    s_nop 0
    buffer_load_dwordx4 v13, s[24:27], s58 offen lds
    s_add_u32 m0, s56, 33792
    s_nop 0
    buffer_load_dwordx4 v9, s[20:23], s57 offen lds
    s_add_u32 m0, s56, 100352
    s_nop 0
    buffer_load_dwordx4 v14, s[24:27], s58 offen lds
    s_add_u32 m0, s56, 34816
    s_nop 0
    buffer_load_dwordx4 v10, s[20:23], s57 offen lds
    s_add_u32 m0, s56, 101376
    s_nop 0
    buffer_load_dwordx4 v15, s[24:27], s58 offen lds
    s_add_u32 m0, s56, 35840
    s_add_u32 s66, s57, 128
    buffer_load_dwordx4 v11, s[20:23], s57 offen lds
    s_add_u32 s58, s58, 0x20000
    s_cmp_ge_u32 s66, 0x800
    s_cselect_b32 s57, 0x40000000, s66

    s_waitcnt vmcnt(8)
    s_barrier
    s_mov_b32 s67, 0
L_lloop:
    s_add_u32 m0, s56, 114688
    s_nop 0
    buffer_load_dwordx4 v12, s[24:27], s58 offen lds
    s_add_u32 m0, s56, 49152
    s_nop 0
    buffer_load_dwordx4 v8, s[20:23], s57 offen lds
    s_add_u32 m0, s56, 115712
    s_nop 0
    buffer_load_dwordx4 v13, s[24:27], s58 offen lds
    s_add_u32 m0, s56, 50176
    s_nop 0
    buffer_load_dwordx4 v9, s[20:23], s57 offen lds
    s_add_u32 m0, s56, 116736
    s_nop 0
    buffer_load_dwordx4 v14, s[24:27], s58 offen lds
    s_add_u32 m0, s56, 51200
    s_nop 0
    buffer_load_dwordx4 v10, s[20:23], s57 offen lds
    s_add_u32 m0, s56, 117760
    s_nop 0
    buffer_load_dwordx4 v15, s[24:27], s58 offen lds
    s_add_u32 m0, s56, 52224
    s_add_u32 s66, s57, 128
    buffer_load_dwordx4 v11, s[20:23], s57 offen lds
    s_add_u32 s58, s58, 0x20000
    s_cmp_ge_u32 s66, 0x800
    s_cselect_b32 s57, 0x40000000, s66

    s_waitcnt vmcnt(8)
    s_barrier
    s_add_u32 m0, s56, 65536
    s_nop 0
    buffer_load_dwordx4 v12, s[24:27], s58 offen lds
    s_add_u32 m0, s56, 0
    s_nop 0
    buffer_load_dwordx4 v8, s[20:23], s57 offen lds
    s_add_u32 m0, s56, 66560
    s_nop 0
    buffer_load_dwordx4 v13, s[24:27], s58 offen lds
    s_add_u32 m0, s56, 1024
    s_nop 0
    buffer_load_dwordx4 v9, s[20:23], s57 offen lds
    s_add_u32 m0, s56, 67584
    s_nop 0
    buffer_load_dwordx4 v14, s[24:27], s58 offen lds
    s_add_u32 m0, s56, 2048
    s_nop 0
    buffer_load_dwordx4 v10, s[20:23], s57 offen lds
    s_add_u32 m0, s56, 68608
    s_nop 0
    buffer_load_dwordx4 v15, s[24:27], s58 offen lds
    s_add_u32 m0, s56, 3072
    s_add_u32 s66, s57, 128
    buffer_load_dwordx4 v11, s[20:23], s57 offen lds
    s_add_u32 s58, s58, 0x20000
    s_cmp_ge_u32 s66, 0x800
    s_cselect_b32 s57, 0x40000000, s66

    s_waitcnt vmcnt(8)
    s_barrier
    s_add_u32 m0, s56, 81920
    s_nop 0
    buffer_load_dwordx4 v12, s[24:27], s58 offen lds
    s_add_u32 m0, s56, 16384
    s_nop 0
    buffer_load_dwordx4 v8, s[20:23], s57 offen lds
    s_add_u32 m0, s56, 82944
    s_nop 0
    buffer_load_dwordx4 v13, s[24:27], s58 offen lds
    s_add_u32 m0, s56, 17408
    s_nop 0
    buffer_load_dwordx4 v9, s[20:23], s57 offen lds
    s_add_u32 m0, s56, 83968
    s_nop 0
    buffer_load_dwordx4 v14, s[24:27], s58 offen lds
    s_add_u32 m0, s56, 18432
    s_nop 0
    buffer_load_dwordx4 v10, s[20:23], s57 offen lds
    s_add_u32 m0, s56, 84992
    s_nop 0
    buffer_load_dwordx4 v15, s[24:27], s58 offen lds
    s_add_u32 m0, s56, 19456
    s_add_u32 s66, s57, 128
    buffer_load_dwordx4 v11, s[20:23], s57 offen lds
    s_add_u32 s58, s58, 0x20000
    s_cmp_ge_u32 s66, 0x800
    s_cselect_b32 s57, 0x40000000, s66

    s_waitcnt vmcnt(8)
    s_barrier
    s_add_u32 m0, s56, 98304
    s_nop 0
    buffer_load_dwordx4 v12, s[24:27], s58 offen lds
    s_add_u32 m0, s56, 32768
    s_nop 0
    buffer_load_dwordx4 v8, s[20:23], s57 offen lds
    s_add_u32 m0, s56, 99328
    s_nop 0
    buffer_load_dwordx4 v13, s[24:27], s58 offen lds
    s_add_u32 m0, s56, 33792
    s_nop 0
    buffer_load_dwordx4 v9, s[20:23], s57 offen lds
    s_add_u32 m0, s56, 100352
    s_nop 0
    buffer_load_dwordx4 v14, s[24:27], s58 offen lds
    s_add_u32 m0, s56, 34816
    s_nop 0
    buffer_load_dwordx4 v10, s[20:23], s57 offen lds
    s_add_u32 m0, s56, 101376
    s_nop 0
    buffer_load_dwordx4 v15, s[24:27], s58 offen lds
    s_add_u32 m0, s56, 35840
    s_add_u32 s66, s57, 128
    buffer_load_dwordx4 v11, s[20:23], s57 offen lds
    s_add_u32 s58, s58, 0x20000
    s_cmp_ge_u32 s66, 0x800
    s_cselect_b32 s57, 0x40000000, s66

    s_waitcnt vmcnt(8)
    s_barrier
    s_add_u32 s67, s67, 1
    s_cmp_lt_u32 s67, 3
    s_cbranch_scc1 L_lloop
    s_add_u32 m0, s56, 114688
    s_nop 0
    buffer_load_dwordx4 v12, s[24:27], s58 offen lds
    s_add_u32 m0, s56, 49152
    s_nop 0
    buffer_load_dwordx4 v8, s[20:23], s57 offen lds
    s_add_u32 m0, s56, 115712
    s_nop 0
    buffer_load_dwordx4 v13, s[24:27], s58 offen lds
    s_add_u32 m0, s56, 50176
    s_nop 0
    buffer_load_dwordx4 v9, s[20:23], s57 offen lds
    s_add_u32 m0, s56, 116736
    s_nop 0
    buffer_load_dwordx4 v14, s[24:27], s58 offen lds
    s_add_u32 m0, s56, 51200
    s_nop 0
    buffer_load_dwordx4 v10, s[20:23], s57 offen lds
    s_add_u32 m0, s56, 117760
    s_nop 0
    buffer_load_dwordx4 v15, s[24:27], s58 offen lds
    s_add_u32 m0, s56, 52224
    s_add_u32 s66, s57, 128
    buffer_load_dwordx4 v11, s[20:23], s57 offen lds
    s_add_u32 s58, s58, 0x20000
    s_cmp_ge_u32 s66, 0x800
    s_cselect_b32 s57, 0x40000000, s66

    s_waitcnt vmcnt(8)
    s_barrier
    s_waitcnt vmcnt(0)
    s_barrier
    s_barrier
    s_waitcnt vmcnt(0)
    s_barrier
    s_branch L_store
L_helper:
    s_setprio 3
    s_sub_u32 s54, s50, 12
    s_lshr_b32 s55, s48, 2
    s_and_b32 s56, s48, 3
    s_lshl_b32 s57, s55, 7
    v_add_u32 v4, s57, v2
    v_lshlrev_b32 v5, 11, v4
    s_lshl_b32 s57, s56, 6
    s_lshl_b32 s58, s54, 4
    s_add_u32 s57, s57, s58
    v_add_u32 v5, s57, v5
    s_mov_b32 s73, 0x20000
    buffer_load_dwordx4 v[64:67], v5, s[24:27], 0 offen
    buffer_load_dwordx4 v[68:71], v5, s[24:27], s73 offen
    v_lshlrev_b32 v6, 1, v4
    v_mov_b32 v72, 0
    v_mov_b32 v73, 0
    v_mov_b32 v74, 0
    v_mov_b32 v75, 0
    buffer_load_short_d16_hi v72, v6, s[32:35], 0 offen
    buffer_load_short_d16_hi v73, v6, s[32:35], 0 offen offset:128
    buffer_load_short_d16_hi v74, v6, s[36:39], 0 offen
    buffer_load_short_d16_hi v75, v6, s[36:39], 0 offen offset:128
    s_lshr_b32 s57, s2, 3
    s_lshl_b32 s57, s57, 2
    v_lshrrev_b32 v7, 4, v2
    v_add_u32 v7, s57, v7
    v_lshlrev_b32 v7, 11, v7
    v_and_b32 v8, 15, v2
    v_lshl_add_u32 v7, v8, 7, v7
    s_mov_b32 s68, s10
    s_and_b32 s69, s11, 0xffff
    s_mov_b32 s70, 0x200000
    s_mov_b32 s71, 0x00020000
    s_add_u32 s74, s54, 2
    s_lshl_b32 s74, s74, 18
    s_add_u32 s75, s74, 0x100000
    s_waitcnt vmcnt(0)

    v_lshlrev_b32 v8, 16, v64
    v_and_b32 v9, s51, v64
    v_mul_f32 v10, v72, v8
    v_mul_f32 v11, v72, v9
    v_cvt_pk_bf16_f32 v12, v10, v11

    v_mul_f32 v81, v74, v8
    v_mul_f32 v83, v74, v9
    v_lshlrev_b32 v80, 16, v12
    v_and_b32 v82, s51, v12

    v_lshlrev_b32 v14, 16, v65
    v_and_b32 v15, s51, v65
    v_mul_f32 v16, v72, v14
    v_mul_f32 v17, v72, v15
    v_cvt_pk_bf16_f32 v18, v16, v17

    v_mul_f32 v85, v74, v14
    v_mul_f32 v87, v74, v15
    v_lshlrev_b32 v84, 16, v18
    v_and_b32 v86, s51, v18

    v_lshlrev_b32 v8, 16, v66
    v_and_b32 v9, s51, v66
    v_mul_f32 v10, v72, v8
    v_mul_f32 v11, v72, v9
    v_cvt_pk_bf16_f32 v12, v10, v11

    v_mul_f32 v89, v74, v8
    v_mul_f32 v91, v74, v9
    v_lshlrev_b32 v88, 16, v12
    v_and_b32 v90, s51, v12

    v_lshlrev_b32 v14, 16, v67
    v_and_b32 v15, s51, v67
    v_mul_f32 v16, v72, v14
    v_mul_f32 v17, v72, v15
    v_cvt_pk_bf16_f32 v18, v16, v17

    v_mul_f32 v93, v74, v14
    v_mul_f32 v95, v74, v15
    v_lshlrev_b32 v92, 16, v18
    v_and_b32 v94, s51, v18

    v_lshlrev_b32 v8, 16, v68
    v_and_b32 v9, s51, v68
    v_mul_f32 v10, v73, v8
    v_mul_f32 v11, v73, v9
    v_cvt_pk_bf16_f32 v12, v10, v11

    v_fmac_f32 v81, v75, v8
    v_fmac_f32 v83, v75, v9
    v_lshlrev_b32 v10, 16, v12
    v_and_b32 v11, s51, v12
    v_add_f32 v80, v80, v10
    v_add_f32 v82, v82, v11

    v_lshlrev_b32 v14, 16, v69
    v_and_b32 v15, s51, v69
    v_mul_f32 v16, v73, v14
    v_mul_f32 v17, v73, v15
    v_cvt_pk_bf16_f32 v18, v16, v17

    v_fmac_f32 v85, v75, v14
    v_fmac_f32 v87, v75, v15
    v_lshlrev_b32 v16, 16, v18
    v_and_b32 v17, s51, v18
    v_add_f32 v84, v84, v16
    v_add_f32 v86, v86, v17

    v_lshlrev_b32 v8, 16, v70
    v_and_b32 v9, s51, v70
    v_mul_f32 v10, v73, v8
    v_mul_f32 v11, v73, v9
    v_cvt_pk_bf16_f32 v12, v10, v11

    v_fmac_f32 v89, v75, v8
    v_fmac_f32 v91, v75, v9
    v_lshlrev_b32 v10, 16, v12
    v_and_b32 v11, s51, v12
    v_add_f32 v88, v88, v10
    v_add_f32 v90, v90, v11

    v_lshlrev_b32 v14, 16, v71
    v_and_b32 v15, s51, v71
    v_mul_f32 v16, v73, v14
    v_mul_f32 v17, v73, v15
    v_cvt_pk_bf16_f32 v18, v16, v17

    v_fmac_f32 v93, v75, v14
    v_fmac_f32 v95, v75, v15
    v_lshlrev_b32 v16, 16, v18
    v_and_b32 v17, s51, v18
    v_add_f32 v92, v92, v16
    v_add_f32 v94, v94, v17

    s_nop 1
    v_permlane32_swap_b32 v80, v88
    v_permlane32_swap_b32 v81, v89
    v_permlane32_swap_b32 v82, v90
    v_permlane32_swap_b32 v83, v91
    v_permlane32_swap_b32 v84, v92
    v_permlane32_swap_b32 v85, v93
    v_permlane32_swap_b32 v86, v94
    v_permlane32_swap_b32 v87, v95
    v_add_f32 v80, v80, v88
    v_add_f32 v81, v81, v89
    v_add_f32 v82, v82, v90
    v_add_f32 v83, v83, v91
    v_add_f32 v84, v84, v92
    v_add_f32 v85, v85, v93
    v_add_f32 v86, v86, v94
    v_add_f32 v87, v87, v95
    s_nop 1
    v_permlane16_swap_b32 v80, v84
    v_permlane16_swap_b32 v81, v85
    v_permlane16_swap_b32 v82, v86
    v_permlane16_swap_b32 v83, v87
    v_add_f32 v80, v80, v84
    v_add_f32 v81, v81, v85
    v_add_f32 v82, v82, v86
    v_add_f32 v83, v83, v87
    s_nop 0
    v_add_f32_dpp v80, v80, v80 quad_perm:[1,0,3,2] row_mask:0xf bank_mask:0xf
    v_add_f32_dpp v81, v81, v81 quad_perm:[1,0,3,2] row_mask:0xf bank_mask:0xf
    v_add_f32_dpp v82, v82, v82 quad_perm:[1,0,3,2] row_mask:0xf bank_mask:0xf
    v_add_f32_dpp v83, v83, v83 quad_perm:[1,0,3,2] row_mask:0xf bank_mask:0xf
    s_nop 0
    v_add_f32_dpp v80, v80, v80 quad_perm:[2,3,0,1] row_mask:0xf bank_mask:0xf
    v_add_f32_dpp v81, v81, v81 quad_perm:[2,3,0,1] row_mask:0xf bank_mask:0xf
    v_add_f32_dpp v82, v82, v82 quad_perm:[2,3,0,1] row_mask:0xf bank_mask:0xf
    v_add_f32_dpp v83, v83, v83 quad_perm:[2,3,0,1] row_mask:0xf bank_mask:0xf
    s_nop 0
    v_add_f32_dpp v80, v80, v80 row_half_mirror row_mask:0xf bank_mask:0xf
    v_add_f32_dpp v81, v81, v81 row_half_mirror row_mask:0xf bank_mask:0xf
    v_add_f32_dpp v82, v82, v82 row_half_mirror row_mask:0xf bank_mask:0xf
    v_add_f32_dpp v83, v83, v83 row_half_mirror row_mask:0xf bank_mask:0xf
    s_nop 0
    v_add_f32_dpp v80, v80, v80 row_mirror row_mask:0xf bank_mask:0xf
    v_add_f32_dpp v81, v81, v81 row_mirror row_mask:0xf bank_mask:0xf
    v_add_f32_dpp v82, v82, v82 row_mirror row_mask:0xf bank_mask:0xf
    v_add_f32_dpp v83, v83, v83 row_mirror row_mask:0xf bank_mask:0xf
    s_lshl_b32 s57, s48, 3
    s_add_u32 s57, s57, s49
    s_lshl_b32 s58, s57, 9
    s_lshl_b32 s59, s54, 6
    s_add_u32 s59, s59, s58
    s_add_u32 s59, s59, 128
    v_add_u32 v8, s59, v2
    s_mov_b32 exec_lo, 0x00010001
    s_mov_b32 exec_hi, 0x00010001
    buffer_store_dwordx4 v[80:83], v8, s[40:43], 0 offen sc0 sc1
    s_mov_b64 exec, -1
    s_setprio 0

    s_barrier
    s_cmp_lg_u32 s54, 0
    s_cbranch_scc1 L_hnorow
    v_lshlrev_b32 v9, 4, v2
    v_add_u32 v10, 133120, v9
    v_add_u32 v9, s58, v9
    s_mov_b64 exec, 0xff
    ds_read_b128 v[12:15], v10
    s_waitcnt lgkmcnt(0)
    buffer_store_dwordx4 v[12:15], v9, s[40:43], 0 offen sc0 sc1
    s_mov_b64 exec, -1

L_hnorow:
    s_barrier
    s_barrier
    s_waitcnt vmcnt(0)
    s_barrier
    v_mov_b32 v9, 1
    v_mov_b32 v10, s57
    s_and_b32 s79, s57, 3
    s_lshl_b32 s80, s54, 2
    s_add_u32 s79, s79, s80

    s_cmp_lg_u32 s79, 0
    s_cbranch_scc1 L_hnf0
    s_mov_b64 exec, 1
    buffer_store_byte v9, v10, s[44:47], 0 offen sc0 sc1
    s_mov_b64 exec, -1

L_hnf0:
    s_barrier
    s_cmp_lg_u32 s79, 1
    s_cbranch_scc1 L_hnf1
    s_mov_b64 exec, 1
    buffer_store_byte v9, v10, s[44:47], 0 offen sc0 sc1
    s_mov_b64 exec, -1

L_hnf1:
    s_barrier
    s_cmp_lg_u32 s79, 2
    s_cbranch_scc1 L_hnf2
    s_mov_b64 exec, 1
    buffer_store_byte v9, v10, s[44:47], 0 offen sc0 sc1
    s_mov_b64 exec, -1

L_hnf2:
    s_barrier
    s_cmp_lg_u32 s79, 3
    s_cbranch_scc1 L_hnf3
    s_mov_b64 exec, 1
    buffer_store_byte v9, v10, s[44:47], 0 offen sc0 sc1
    s_mov_b64 exec, -1

L_hnf3:
    s_barrier
    s_barrier
    s_barrier
    s_barrier
    s_barrier
    s_cmp_ge_u32 s54, 2
    s_cbranch_scc1 L_hg_idle
    s_lshl_b32 s57, s48, 3
    v_mov_b32 v8, s57
    v_and_b32 v9, 7, v2
    v_add_u32 v8, v8, v9
    v_and_b32 v9, 31, v2
    v_lshlrev_b32 v9, 3, v9
    v_add_u32 v9, s49, v9
    s_cmp_eq_u32 s54, 1
    s_cselect_b64 vcc, -1, 0
    s_nop 1
    v_cndmask_b32 v8, v8, v9, vcc
    buffer_load_ubyte v10, v8, s[44:47], 0 offen sc1
    s_lshl_b32 s57, s48, 12
    v_lshrrev_b32 v11, 3, v2
    v_lshlrev_b32 v11, 9, v11
    v_and_b32 v9, 7, v2
    v_lshl_add_u32 v11, v9, 4, v11
    v_add_u32 v11, s57, v11
    v_lshrrev_b32 v12, 4, v2
    v_lshlrev_b32 v12, 12, v12
    v_and_b32 v9, 15, v2
    v_lshl_add_u32 v12, v9, 4, v12
    s_lshl_b32 s57, s49, 9
    s_add_u32 s57, s57, 128
    v_add_u32 v12, s57, v12

    s_barrier
    s_barrier
L_hg_poll:
    s_waitcnt vmcnt(0)
    v_cmp_ne_u32 vcc, 1, v10
    s_cbranch_vccz L_hg_ok
    s_sleep 8
    buffer_load_ubyte v10, v8, s[44:47], 0 offen sc1
    s_branch L_hg_poll

L_hg_ok:
    s_cmp_eq_u32 s54, 1
    s_cbranch_scc1 L_hg_cols
    buffer_load_dwordx4 v[32:35], v11, s[40:43], 0 offen sc1

    s_barrier
    s_barrier
    v_lshlrev_b32 v9, 3, v2
    v_add_u32 v9, 132096, v9
    s_waitcnt vmcnt(0)
    s_branch L_hg_wr

L_hg_cols:
    s_mov_b32 s57, 0
    buffer_load_dwordx4 v[32:35], v12, s[40:43], s57 offen sc1
    s_mov_b32 s57, 16384
    buffer_load_dwordx4 v[36:39], v12, s[40:43], s57 offen sc1
    s_mov_b32 s57, 32768
    buffer_load_dwordx4 v[40:43], v12, s[40:43], s57 offen sc1
    s_mov_b32 s57, 49152
    buffer_load_dwordx4 v[44:47], v12, s[40:43], s57 offen sc1
    s_mov_b32 s57, 65536
    buffer_load_dwordx4 v[48:51], v12, s[40:43], s57 offen sc1
    s_mov_b32 s57, 81920
    buffer_load_dwordx4 v[52:55], v12, s[40:43], s57 offen sc1
    s_mov_b32 s57, 98304
    buffer_load_dwordx4 v[56:59], v12, s[40:43], s57 offen sc1
    s_mov_b32 s57, 114688
    buffer_load_dwordx4 v[60:63], v12, s[40:43], s57 offen sc1
    s_barrier
    s_barrier
    v_lshlrev_b32 v9, 3, v2
    v_add_u32 v9, 131072, v9
    s_waitcnt vmcnt(0)

    v_add_f32 v32, v32, v36
    v_add_f32 v33, v33, v37
    v_add_f32 v34, v34, v38
    v_add_f32 v35, v35, v39
    v_add_f32 v32, v32, v40
    v_add_f32 v33, v33, v41
    v_add_f32 v34, v34, v42
    v_add_f32 v35, v35, v43
    v_add_f32 v32, v32, v44
    v_add_f32 v33, v33, v45
    v_add_f32 v34, v34, v46
    v_add_f32 v35, v35, v47
    v_add_f32 v32, v32, v48
    v_add_f32 v33, v33, v49
    v_add_f32 v34, v34, v50
    v_add_f32 v35, v35, v51
    v_add_f32 v32, v32, v52
    v_add_f32 v33, v33, v53
    v_add_f32 v34, v34, v54
    v_add_f32 v35, v35, v55
    v_add_f32 v32, v32, v56
    v_add_f32 v33, v33, v57
    v_add_f32 v34, v34, v58
    v_add_f32 v35, v35, v59
    v_add_f32 v32, v32, v60
    v_add_f32 v33, v33, v61
    v_add_f32 v34, v34, v62
    v_add_f32 v35, v35, v63
L_hg_wr:
    ds_write2_b32 v9, v32, v34 offset0:0 offset1:1
    ds_write2_b32 v9, v33, v35 offset0:128 offset1:129
    s_branch L_hg_done

L_hg_idle:
    s_barrier
    s_barrier
    s_barrier
    s_barrier
L_hg_done:
    s_waitcnt vmcnt(0) lgkmcnt(0)
    s_barrier
L_store:
    v_add_u32 v3, 0, v0
    v_lshrrev_b32 v4, 4, v3
    v_and_b32 v5, 15, v3
    v_and_b32 v6, 7, v4
    v_xor_b32 v6, v5, v6
    v_lshlrev_b32 v7, 8, v4
    v_lshl_add_u32 v12, v6, 4, v7
    v_lshlrev_b32 v7, 11, v4
    v_lshl_add_u32 v14, v5, 4, v7

    v_add_u32 v3, 1024, v0
    v_lshrrev_b32 v4, 4, v3
    v_and_b32 v5, 15, v3
    v_and_b32 v6, 7, v4
    v_xor_b32 v6, v5, v6
    v_lshlrev_b32 v7, 8, v4
    v_lshl_add_u32 v13, v6, 4, v7
    v_lshlrev_b32 v7, 11, v4
    v_lshl_add_u32 v15, v5, 4, v7

    s_waitcnt lgkmcnt(0)
    s_barrier
    ds_read_b128 v[16:19], v12 offset:32768
    ds_read_b128 v[20:23], v13 offset:32768
    s_waitcnt lgkmcnt(1)
    buffer_store_dwordx4 v[16:19], v14, s[28:31], 0 offen sc0 sc1
    s_waitcnt lgkmcnt(0)
    buffer_store_dwordx4 v[20:23], v15, s[28:31], 0 offen sc0 sc1
L_exit:
s_endpgm
.section .rodata,"a"
.p2align 6
.amdhsa_kernel standalone__layernorm_linear__sampling_kernel
  .amdhsa_next_free_vgpr 128
  .amdhsa_next_free_sgpr 102
  .amdhsa_accum_offset 128
  .amdhsa_group_segment_fixed_size 0
  .amdhsa_float_denorm_mode_32 3
  .amdhsa_float_denorm_mode_16_64 3
  .amdhsa_kernarg_size 56
  .amdhsa_user_sgpr_count 2
  .amdhsa_user_sgpr_kernarg_segment_ptr 1
  .amdhsa_system_sgpr_workgroup_id_x 1
.end_amdhsa_kernel
```
